```python
import torch

def _softmax(x, axis=-1):
    return torch.softmax(x, dim=axis)
def _gelu(x):
    return torch.nn.functional.gelu(x, approximate="tanh")
def _silu(x):
    return torch.nn.functional.silu(x)
def _sigmoid(x):
    return torch.sigmoid(x)
def _layernorm(x, axis=-1, eps=1e-5):
    m = x.mean(dim=axis, keepdim=True)
    v = x.var(dim=axis, keepdim=True, unbiased=False)
    return (x - m) / torch.sqrt(v + eps)
def _scatter_add(tgt, idx, src, axis=0):
    return tgt.clone().index_add_(axis, idx, src)
def _segment_sum(src, seg, n):
    out = torch.zeros((n,) + src.shape[1:], dtype=src.dtype)
    return out.index_add_(0, seg, src)
def _pad(x, pw):
    flat = tuple(v for pair in reversed(pw) for v in pair)
    return torch.nn.functional.pad(x, flat)

kernel_name = 'standalone__normalfloat_lut_codebook_lookup__prompt'

def setup_inputs():

    _w = (lambda a: (lambda t: t.to(torch.bfloat16) if t.is_floating_point() else t)(torch.as_tensor(a)))
    B, S, D, F = 1, 2048, 1024, 3584
    G = 32 if 32 > 0 else D
    D = (D // G) * G
    ng = D // G
    nf4 = torch.tensor([
        -1.0, -0.6961928009986877, -0.5250730514526367, -0.39491748809814453,
        -0.28444138169288635, -0.18477343022823334, -0.09105003625154495, 0.0,
        0.07958029955625534, 0.16093020141124725, 0.24611230194568634, 0.33791524171829224,
        0.44070982933044434, 0.5626170039176941, 0.7229568362236023, 1.0
    ], dtype=float)
    qw = torch.randint(0, 16, (D, F)).to(torch.int64)
    absmax = (torch.abs((lambda *s: torch.randn(*s, dtype=torch.bfloat16) * 0.05)(ng, F)) + 0.01).to(float)
    return {
        "x": _w((lambda *s: torch.randn(*s, dtype=torch.bfloat16) * 0.05)(B, S, D)),
        "qw": _w(qw),
        "codebook": _w(nf4),
        "absmax": _w(absmax),
    }

def reference(x, qw, codebook, absmax):
    B, S, D = x.shape
    ng, F = absmax.shape
    G = D // ng
    w_nf = codebook[qw]
    s = (lambda x, n, axis: torch.repeat_interleave(x, n, dim=axis))(absmax, G, axis=0)
    w = (lambda x, dt: x.to(dt))(w_nf * s, x.dtype)
    return torch.einsum("bsd,df->bsf", x, w)
```

```asm
; @launch grid=(256,1,1) block=(768,1,1) lds=155904
.amdgcn_target "amdgcn-amd-amdhsa--gfx950"
.text
.globl standalone__normalfloat_lut_codebook_lookup__prompt_kernel
.p2align 8
.type standalone__normalfloat_lut_codebook_lookup__prompt_kernel,@function
standalone__normalfloat_lut_codebook_lookup__prompt_kernel:
    s_load_dwordx8 s[4:11], s[0:1], 0
    s_load_dwordx2 s[12:13], s[0:1], 32
    v_lshrrev_b32 v1, 6, v0
    v_and_b32 v0, 63, v0
    v_readfirstlane_b32 s38, v1
    s_cmp_ge_u32 s2, 256
    s_cbranch_scc1 L_end
    s_cmp_ge_u32 s2, 32
    s_cbranch_scc1 L_comp
    s_cmp_lg_u32 s38, 0
    s_cbranch_scc1 L_end
    s_lshr_b32 s36, s2, 3
    v_lshlrev_b32 v1, 11, v0
    s_and_b32 s14, s2, 1
    s_bfe_u32 s15, s2, 0x20001
    s_lshl_b32 s37, s14, 4
    s_lshl_b32 s38, s15, 2
    s_add_u32 s37, s37, s38
    s_add_u32 s37, s37, s36
    s_lshl_b32 s37, s37, 17
    v_lshrrev_b32 v2, 5, v0
    v_mul_u32_u24 v2, 14336, v2
    v_and_b32 v3, 31, v0
    v_lshl_add_u32 v2, v3, 7, v2
    v_cmp_gt_u32 vcc, 28, v3
    v_mov_b32 v4, 0x7fffffff
    s_lshl_b32 s38, s14, 2
    v_cndmask_b32 v2, v4, v2, vcc
    s_add_u32 s38, s38, s36
    s_lshl_b32 s38, s38, 3
    s_add_u32 s38, s38, 64
    s_mul_i32 s38, s38, 14336
    s_mul_i32 s39, s15, 3584
    s_add_u32 s38, s38, s39
    s_waitcnt lgkmcnt(0)
    s_mov_b32 s16, s4
    s_and_b32 s17, s5, 0xffff
    s_mov_b32 s18, 4194304
    s_mov_b32 s19, 0x20000
    s_mov_b32 s20, s6
    s_and_b32 s21, s7, 0xffff
    s_mov_b32 s22, 14680064
    s_mov_b32 s23, 0x20000
    buffer_load_dword v5, v1, s[16:19], s37 offen offset:0
    s_add_u32 s37, s37, 128
    s_mov_b32 s40, 15
L_hloop:
    buffer_load_dword v5, v2, s[20:23], s38 offen
    s_add_u32 s38, s38, 28672
    buffer_load_dword v5, v2, s[20:23], s38 offen
    s_add_u32 s38, s38, 28672
    buffer_load_dword v5, v2, s[20:23], s38 offen
    s_add_u32 s38, s38, 28672
    buffer_load_dword v5, v2, s[20:23], s38 offen
    s_add_u32 s38, s38, 831488
    buffer_load_dword v5, v1, s[16:19], s37 offen
    s_add_u32 s37, s37, 128
    s_waitcnt vmcnt(20)
    s_sub_u32 s40, s40, 1
    s_cmp_lg_u32 s40, 0
    s_cbranch_scc1 L_hloop
    s_endpgm
L_comp:
    s_sub_u32 s53, s2, 32
    s_lshr_b32 s15, s53, 3
    s_and_b32 s14, s53, 1
    s_lshl_b32 s14, s14, 2
    s_and_b32 s37, s15, 3
    s_add_u32 s37, s37, s14
    s_bfe_u32 s14, s53, 0x20001
    s_mul_i32 s14, s14, 7
    s_lshr_b32 s36, s15, 2
    s_add_u32 s36, s36, s14
    s_cmp_lt_u32 s38, 4
    s_cbranch_scc1 L_cons
L_prod:
    s_sub_u32 s38, s38, 4
    s_lshr_b32 s41, s38, 2
    s_cmp_lg_u32 s41, 0
    s_setprio 2
    s_cbranch_scc1 L_noprio
    s_setprio 3
L_noprio:
    v_and_b32 v104, 31, v0
    v_lshrrev_b32 v105, 5, v0
    v_mul_u32_u24 v1, 114688, v105
    v_lshl_add_u32 v1, v104, 4, v1
    v_add_u32 v2, 14336, v1
    v_add_u32 v3, 28672, v1
    v_add_u32 v4, 43008, v1
    v_lshlrev_b32 v11, 3, v104
    v_lshlrev_b32 v109, 1, v0
    s_mul_i32 s43, s38, 229376
    s_lshl_b32 s42, s36, 9
    s_add_u32 s43, s43, s42
    s_lshr_b32 s50, s38, 1
    s_mul_i32 s51, s50, 7168
    s_lshl_b32 s42, s36, 8
    s_add_u32 s51, s51, s42
    s_mov_b32 s22, 14680064
    s_mov_b32 s23, 0x20000
    s_mov_b32 s34, 32
    s_mov_b32 s35, 0x20000
    s_mov_b32 s26, 229376
    s_mov_b32 s27, 0x20000
    s_mov_b32 s18, 4194304
    s_mov_b32 s19, 0x20000
    s_waitcnt lgkmcnt(0)
    s_mov_b32 s32, s8
    s_and_b32 s33, s9, 0xffff
    s_cmp_eq_u32 s41, 0
    s_cbranch_scc1 L_notb0
    v_lshrrev_b32 v116, 2, v0
    v_lshlrev_b32 v116, 1, v116
    s_lshl_b32 s58, s38, 3
    s_sub_u32 s58, s58, 32
    v_mov_b32 v117, s58
    buffer_load_ushort v118, v116, s[32:35], 0 offen
    buffer_load_dwordx2 v[120:121], v117, s[32:35], 0 offen
L_notb0:
    buffer_load_ushort v110, v109, s[32:35], 0 offen
    s_mov_b32 s24, s10
    s_and_b32 s25, s11, 0xffff
    buffer_load_dwordx2 v[12:13], v11, s[24:27], s51 offen
    s_mov_b32 s20, s6
    s_and_b32 s21, s7, 0xffff
    s_add_u32 s48, s43, 57344
    buffer_load_dwordx4 v[36:39], v1, s[20:23], s43 offen
    buffer_load_dwordx4 v[40:43], v2, s[20:23], s43 offen
    buffer_load_dwordx4 v[44:47], v3, s[20:23], s43 offen
    buffer_load_dwordx4 v[48:51], v4, s[20:23], s43 offen
    buffer_load_dwordx4 v[52:55], v1, s[20:23], s48 offen
    buffer_load_dwordx4 v[56:59], v2, s[20:23], s48 offen
    buffer_load_dwordx4 v[60:63], v3, s[20:23], s48 offen
    buffer_load_dwordx4 v[64:67], v4, s[20:23], s48 offen
    s_add_u32 s43, s43, 1835008
    s_mov_b32 s16, s4
    s_and_b32 s17, s5, 0xffff
    s_and_b32 s40, s38, 3
    v_lshrrev_b32 v111, 4, v0
    v_and_b32 v112, 7, v0
    v_xor_b32 v112, v112, v111
    v_lshrrev_b32 v111, 3, v0
    v_lshlrev_b32 v111, 11, v111
    v_lshl_add_u32 v5, v112, 4, v111
    v_xor_b32 v6, 64, v5
    v_add_u32 v7, 30720, v5
    v_add_u32 v8, 46080, v6
    v_add_u32 v6, 15360, v6
    s_lshl_b32 s44, s37, 2
    s_add_u32 s44, s44, s40
    s_lshl_b32 s44, s44, 17
    s_lshl_b32 s42, s41, 7
    s_sub_u32 s42, 256, s42
    s_add_u32 s44, s44, s42
    s_lshl_b32 s45, s40, 13
    s_add_u32 s45, s45, 41216
    s_lshl_b32 s46, s41, 16
    v_and_b32 v111, 15, v104
    v_lshrrev_b32 v112, 4, v104
    v_lshlrev_b32 v112, 12, v112
    v_lshl_add_u32 v112, v105, 8, v112
    v_lshl_add_u32 v112, v111, 4, v112
    s_lshl_b32 s42, s50, 13
    s_and_b32 s58, s38, 1
    s_lshl_b32 s58, s58, 9
    s_add_u32 s42, s42, s58
    s_add_u32 s42, s42, 8448
    v_add_u32 v9, s42, v112
    s_lshl_b32 s50, s50, 8
    s_add_u32 s50, s50, 1280
    v_add_u32 v11, s50, v11
    v_and_b32 v18, 7, v0
    v_lshlrev_b32 v18, 3, v18
    v_add_u32 v18, 139520, v18
    s_waitcnt vmcnt(9)
    v_lshlrev_b32 v110, 16, v110
    v_lshlrev_b32 v109, 2, v0
    ds_write_b32 v109, v110 offset:0
    s_cmp_eq_u32 s41, 0
    s_cbranch_scc1 L_notb1
    s_lshl_b32 s58, s40, 12
    s_add_u32 s58, s58, 139520
    v_lshl_add_u32 v116, v0, 4, s58
    v_lshlrev_b32 v124, 16, v118
    v_mov_b32 v126, v124
    v_lshlrev_b32 v125, 16, v120
    v_mov_b32 v127, v125
    ds_write_b128 v116, v[124:127] offset:0
    s_nop 1
    v_and_b32 v125, 0xffff0000, v120
    v_mov_b32 v127, v125
    ds_write_b128 v116, v[124:127] offset:1024
    s_nop 1
    v_lshlrev_b32 v125, 16, v121
    v_mov_b32 v127, v125
    ds_write_b128 v116, v[124:127] offset:2048
    s_nop 1
    v_and_b32 v125, 0xffff0000, v121
    v_mov_b32 v127, v125
    ds_write_b128 v116, v[124:127] offset:3072
    s_nop 1
L_notb1:
    s_waitcnt vmcnt(6)
    v_lshlrev_b32 v36, 2, v36
    v_lshlrev_b32 v37, 2, v37
    v_lshlrev_b32 v38, 2, v38
    v_lshlrev_b32 v39, 2, v39
    v_lshlrev_b32 v40, 2, v40
    v_lshlrev_b32 v41, 2, v41
    v_lshlrev_b32 v42, 2, v42
    v_lshlrev_b32 v43, 2, v43
    ds_read_b32 v36, v36 offset:0
    ds_read_b32 v37, v37 offset:0
    ds_read_b32 v38, v38 offset:0
    ds_read_b32 v39, v39 offset:0
    ds_read_b32 v40, v40 offset:0
    ds_read_b32 v41, v41 offset:0
    ds_read_b32 v42, v42 offset:0
    ds_read_b32 v43, v43 offset:0
    s_waitcnt vmcnt(4)
    v_lshlrev_b32 v44, 2, v44
    v_lshlrev_b32 v45, 2, v45
    v_lshlrev_b32 v46, 2, v46
    v_lshlrev_b32 v47, 2, v47
    v_lshlrev_b32 v48, 2, v48
    v_lshlrev_b32 v49, 2, v49
    v_lshlrev_b32 v50, 2, v50
    v_lshlrev_b32 v51, 2, v51
    ds_read_b32 v44, v44 offset:0
    ds_read_b32 v45, v45 offset:0
    ds_read_b32 v46, v46 offset:0
    ds_read_b32 v47, v47 offset:0
    ds_read_b32 v48, v48 offset:0
    ds_read_b32 v49, v49 offset:0
    ds_read_b32 v50, v50 offset:0
    ds_read_b32 v51, v51 offset:0
    s_waitcnt vmcnt(2)
    v_lshlrev_b32 v52, 2, v52
    v_lshlrev_b32 v53, 2, v53
    v_lshlrev_b32 v54, 2, v54
    v_lshlrev_b32 v55, 2, v55
    v_lshlrev_b32 v56, 2, v56
    v_lshlrev_b32 v57, 2, v57
    v_lshlrev_b32 v58, 2, v58
    v_lshlrev_b32 v59, 2, v59
    ds_read_b32 v52, v52 offset:0
    ds_read_b32 v53, v53 offset:0
    ds_read_b32 v54, v54 offset:0
    ds_read_b32 v55, v55 offset:0
    ds_read_b32 v56, v56 offset:0
    ds_read_b32 v57, v57 offset:0
    ds_read_b32 v58, v58 offset:0
    ds_read_b32 v59, v59 offset:0
    s_waitcnt vmcnt(0)
    v_lshlrev_b32 v60, 2, v60
    v_lshlrev_b32 v61, 2, v61
    v_lshlrev_b32 v62, 2, v62
    v_lshlrev_b32 v63, 2, v63
    v_lshlrev_b32 v64, 2, v64
    v_lshlrev_b32 v65, 2, v65
    v_lshlrev_b32 v66, 2, v66
    v_lshlrev_b32 v67, 2, v67
    ds_read_b32 v60, v60 offset:0
    ds_read_b32 v61, v61 offset:0
    ds_read_b32 v62, v62 offset:0
    ds_read_b32 v63, v63 offset:0
    ds_read_b32 v64, v64 offset:0
    ds_read_b32 v65, v65 offset:0
    ds_read_b32 v66, v66 offset:0
    ds_read_b32 v67, v67 offset:0
    s_waitcnt lgkmcnt(0)
    v_lshlrev_b32 v14, 16, v12
    v_and_b32 v15, 0xffff0000, v12
    v_lshlrev_b32 v16, 16, v13
    v_and_b32 v17, 0xffff0000, v13
    v_mul_f32 v36, v14, v36
    v_mul_f32 v37, v15, v37
    v_mul_f32 v38, v16, v38
    v_mul_f32 v39, v17, v39
    v_mul_f32 v40, v14, v40
    v_mul_f32 v41, v15, v41
    v_mul_f32 v42, v16, v42
    v_mul_f32 v43, v17, v43
    v_cvt_pk_bf16_f32 v20, v36, v40
    v_cvt_pk_bf16_f32 v24, v37, v41
    v_cvt_pk_bf16_f32 v28, v38, v42
    v_cvt_pk_bf16_f32 v32, v39, v43
    v_mul_f32 v44, v14, v44
    v_mul_f32 v45, v15, v45
    v_mul_f32 v46, v16, v46
    v_mul_f32 v47, v17, v47
    v_mul_f32 v48, v14, v48
    v_mul_f32 v49, v15, v49
    v_mul_f32 v50, v16, v50
    v_mul_f32 v51, v17, v51
    v_cvt_pk_bf16_f32 v21, v44, v48
    v_cvt_pk_bf16_f32 v25, v45, v49
    v_cvt_pk_bf16_f32 v29, v46, v50
    v_cvt_pk_bf16_f32 v33, v47, v51
    v_mul_f32 v52, v14, v52
    v_mul_f32 v53, v15, v53
    v_mul_f32 v54, v16, v54
    v_mul_f32 v55, v17, v55
    v_mul_f32 v56, v14, v56
    v_mul_f32 v57, v15, v57
    v_mul_f32 v58, v16, v58
    v_mul_f32 v59, v17, v59
    v_cvt_pk_bf16_f32 v22, v52, v56
    v_cvt_pk_bf16_f32 v26, v53, v57
    v_cvt_pk_bf16_f32 v30, v54, v58
    v_cvt_pk_bf16_f32 v34, v55, v59
    v_mul_f32 v60, v14, v60
    v_mul_f32 v61, v15, v61
    v_mul_f32 v62, v16, v62
    v_mul_f32 v63, v17, v63
    v_mul_f32 v64, v14, v64
    v_mul_f32 v65, v15, v65
    v_mul_f32 v66, v16, v66
    v_mul_f32 v67, v17, v67
    v_cvt_pk_bf16_f32 v23, v60, v64
    v_cvt_pk_bf16_f32 v27, v61, v65
    v_cvt_pk_bf16_f32 v31, v62, v66
    v_cvt_pk_bf16_f32 v35, v63, v67
    ds_write_b128 v9, v[20:23] offset:0
    ds_write_b128 v9, v[24:27] offset:1024
    ds_write_b128 v9, v[28:31] offset:2048
    ds_write_b128 v9, v[32:35] offset:3072
    s_setprio 0
    s_mov_b32 s39, 3
    s_cmp_lg_u32 s41, 0
    s_cbranch_scc1 L_pB
    s_add_u32 s48, s43, 57344
    buffer_load_dwordx4 v[36:39], v1, s[20:23], s43 offen
    buffer_load_dwordx4 v[40:43], v2, s[20:23], s43 offen
    buffer_load_dwordx4 v[44:47], v3, s[20:23], s43 offen
    buffer_load_dwordx4 v[48:51], v4, s[20:23], s43 offen
    buffer_load_dwordx4 v[52:55], v1, s[20:23], s48 offen
    buffer_load_dwordx4 v[56:59], v2, s[20:23], s48 offen
    buffer_load_dwordx4 v[60:63], v3, s[20:23], s48 offen
    buffer_load_dwordx4 v[64:67], v4, s[20:23], s48 offen
    s_add_u32 s43, s43, 1835008
    s_waitcnt lgkmcnt(0)
    s_barrier
    s_branch L_pD
L_pB:
    s_barrier
    s_add_u32 m0, s45, s46
    s_add_u32 s52, s44, 65536
    s_sub_u32 s46, s46, 32768
    s_cselect_b32 s46, 65536, s46
    buffer_load_dwordx4 v5, s[16:19], s44 offen offset:0 lds
    buffer_load_dwordx4 v6, s[16:19], s44 offen offset:1024 lds
    buffer_load_dwordx4 v7, s[16:19], s44 offen offset:2048 lds
    buffer_load_dwordx4 v8, s[16:19], s44 offen offset:3072 lds
    s_add_u32 m0, m0, 4096
    s_add_u32 s44, s44, 256
    buffer_load_dwordx4 v5, s[16:19], s52 offen offset:0 lds
    buffer_load_dwordx4 v6, s[16:19], s52 offen offset:1024 lds
    buffer_load_dwordx4 v7, s[16:19], s52 offen offset:2048 lds
    buffer_load_dwordx4 v8, s[16:19], s52 offen offset:3072 lds
    s_add_u32 s48, s43, 57344
    buffer_load_dwordx4 v[36:39], v1, s[20:23], s43 offen
    buffer_load_dwordx4 v[40:43], v2, s[20:23], s43 offen
    buffer_load_dwordx4 v[44:47], v3, s[20:23], s43 offen
    buffer_load_dwordx4 v[48:51], v4, s[20:23], s43 offen
    buffer_load_dwordx4 v[52:55], v1, s[20:23], s48 offen
    buffer_load_dwordx4 v[56:59], v2, s[20:23], s48 offen
    buffer_load_dwordx4 v[60:63], v3, s[20:23], s48 offen
    buffer_load_dwordx4 v[64:67], v4, s[20:23], s48 offen
    s_add_u32 s43, s43, 1835008
    s_waitcnt vmcnt(8)
    s_branch L_Wdone
L_pL:
    buffer_load_dwordx4 v7, s[16:19], s52 offen offset:2048 lds
    buffer_load_dwordx4 v8, s[16:19], s52 offen offset:3072 lds
L_pL2:
    s_waitcnt lgkmcnt(0)
    v_mul_f32 v60, v14, v60
    v_mul_f32 v61, v15, v61
    v_mul_f32 v62, v16, v62
    v_mul_f32 v63, v17, v63
    v_mul_f32 v64, v14, v64
    v_mul_f32 v65, v15, v65
    v_mul_f32 v66, v16, v66
    v_mul_f32 v67, v17, v67
    v_cvt_pk_bf16_f32 v23, v60, v64
    v_cvt_pk_bf16_f32 v27, v61, v65
    v_cvt_pk_bf16_f32 v31, v62, v66
    v_cvt_pk_bf16_f32 v35, v63, v67
    s_cmp_gt_u32 s39, 15
    s_cbranch_scc0 L_doQ
    s_waitcnt vmcnt(0)
    s_branch L_doW
L_doQ:
    s_add_u32 s48, s43, 57344
    buffer_load_dwordx4 v[36:39], v1, s[20:23], s43 offen
    buffer_load_dwordx4 v[40:43], v2, s[20:23], s43 offen
    buffer_load_dwordx4 v[44:47], v3, s[20:23], s43 offen
    buffer_load_dwordx4 v[48:51], v4, s[20:23], s43 offen
    buffer_load_dwordx4 v[52:55], v1, s[20:23], s48 offen
    buffer_load_dwordx4 v[56:59], v2, s[20:23], s48 offen
    buffer_load_dwordx4 v[60:63], v3, s[20:23], s48 offen
    buffer_load_dwordx4 v[64:67], v4, s[20:23], s48 offen
    s_add_u32 s43, s43, 1835008
    s_waitcnt vmcnt(8)
L_doW:
    ds_write_b128 v9, v[20:23] offset:0
    ds_write_b128 v9, v[24:27] offset:1024
    ds_write_b128 v9, v[28:31] offset:2048
    ds_write_b128 v9, v[32:35] offset:3072
L_Wdone:
    s_waitcnt lgkmcnt(0)
    s_add_u32 s39, s39, 1
    s_cmp_ge_u32 s39, 17
    s_barrier
    s_cbranch_scc1 L_pend
L_pD:
    s_setprio 1
    ds_read_b64 v[12:13], v11
    v_add_u32 v11, 1024, v11
    s_waitcnt vmcnt(6)
    v_lshl_add_u32 v36, v36, 6, v18
    v_lshl_add_u32 v38, v38, 6, v18
    v_lshl_add_u32 v40, v40, 6, v18
    v_lshl_add_u32 v42, v42, 6, v18
    v_lshl_add_u32 v36, v37, 10, v36
    v_lshl_add_u32 v38, v39, 10, v38
    v_lshl_add_u32 v40, v41, 10, v40
    v_lshl_add_u32 v42, v43, 10, v42
    ds_read_b64 v[36:37], v36
    ds_read_b64 v[38:39], v38
    ds_read_b64 v[40:41], v40
    ds_read_b64 v[42:43], v42
    s_waitcnt vmcnt(4)
    v_lshl_add_u32 v44, v44, 6, v18
    v_lshl_add_u32 v46, v46, 6, v18
    v_lshl_add_u32 v48, v48, 6, v18
    v_lshl_add_u32 v50, v50, 6, v18
    v_lshl_add_u32 v44, v45, 10, v44
    v_lshl_add_u32 v46, v47, 10, v46
    v_lshl_add_u32 v48, v49, 10, v48
    v_lshl_add_u32 v50, v51, 10, v50
    ds_read_b64 v[44:45], v44
    ds_read_b64 v[46:47], v46
    ds_read_b64 v[48:49], v48
    ds_read_b64 v[50:51], v50
    s_waitcnt vmcnt(2)
    v_lshl_add_u32 v52, v52, 6, v18
    v_lshl_add_u32 v54, v54, 6, v18
    v_lshl_add_u32 v56, v56, 6, v18
    v_lshl_add_u32 v58, v58, 6, v18
    v_lshl_add_u32 v52, v53, 10, v52
    v_lshl_add_u32 v54, v55, 10, v54
    v_lshl_add_u32 v56, v57, 10, v56
    v_lshl_add_u32 v58, v59, 10, v58
    ds_read_b64 v[52:53], v52
    ds_read_b64 v[54:55], v54
    ds_read_b64 v[56:57], v56
    ds_read_b64 v[58:59], v58
    s_waitcnt vmcnt(0)
    v_lshl_add_u32 v60, v60, 6, v18
    v_lshl_add_u32 v62, v62, 6, v18
    v_lshl_add_u32 v64, v64, 6, v18
    v_lshl_add_u32 v66, v66, 6, v18
    v_lshl_add_u32 v60, v61, 10, v60
    v_lshl_add_u32 v62, v63, 10, v62
    v_lshl_add_u32 v64, v65, 10, v64
    v_lshl_add_u32 v66, v67, 10, v66
    ds_read_b64 v[60:61], v60
    ds_read_b64 v[62:63], v62
    ds_read_b64 v[64:65], v64
    ds_read_b64 v[66:67], v66
    s_waitcnt lgkmcnt(4)
    v_lshlrev_b32 v14, 16, v12
    v_and_b32 v15, 0xffff0000, v12
    v_lshlrev_b32 v16, 16, v13
    v_and_b32 v17, 0xffff0000, v13
    v_mul_f32 v36, v14, v36
    v_mul_f32 v37, v15, v37
    v_mul_f32 v38, v16, v38
    v_mul_f32 v39, v17, v39
    v_mul_f32 v40, v14, v40
    v_mul_f32 v41, v15, v41
    v_mul_f32 v42, v16, v42
    v_mul_f32 v43, v17, v43
    v_cvt_pk_bf16_f32 v20, v36, v40
    v_cvt_pk_bf16_f32 v24, v37, v41
    v_cvt_pk_bf16_f32 v28, v38, v42
    v_cvt_pk_bf16_f32 v32, v39, v43
    v_mul_f32 v44, v14, v44
    v_mul_f32 v45, v15, v45
    v_mul_f32 v46, v16, v46
    v_mul_f32 v47, v17, v47
    v_mul_f32 v48, v14, v48
    v_mul_f32 v49, v15, v49
    v_mul_f32 v50, v16, v50
    v_mul_f32 v51, v17, v51
    v_cvt_pk_bf16_f32 v21, v44, v48
    v_cvt_pk_bf16_f32 v25, v45, v49
    v_cvt_pk_bf16_f32 v29, v46, v50
    v_cvt_pk_bf16_f32 v33, v47, v51
    v_mul_f32 v52, v14, v52
    v_mul_f32 v53, v15, v53
    v_mul_f32 v54, v16, v54
    v_mul_f32 v55, v17, v55
    v_mul_f32 v56, v14, v56
    v_mul_f32 v57, v15, v57
    v_mul_f32 v58, v16, v58
    v_mul_f32 v59, v17, v59
    v_cvt_pk_bf16_f32 v22, v52, v56
    v_cvt_pk_bf16_f32 v26, v53, v57
    v_cvt_pk_bf16_f32 v30, v54, v58
    v_cvt_pk_bf16_f32 v34, v55, v59
    s_setprio 0
    s_add_u32 m0, s45, s46
    s_add_u32 s52, s44, 65536
    s_sub_u32 s46, s46, 32768
    s_cselect_b32 s46, 65536, s46
    buffer_load_dwordx4 v5, s[16:19], s44 offen offset:0 lds
    buffer_load_dwordx4 v6, s[16:19], s44 offen offset:1024 lds
    buffer_load_dwordx4 v7, s[16:19], s44 offen offset:2048 lds
    buffer_load_dwordx4 v8, s[16:19], s44 offen offset:3072 lds
    s_add_u32 m0, m0, 4096
    s_add_u32 s44, s44, 256
    buffer_load_dwordx4 v5, s[16:19], s52 offen offset:0 lds
    buffer_load_dwordx4 v6, s[16:19], s52 offen offset:1024 lds
    s_add_u32 s39, s39, 1
    s_barrier
    s_branch L_pL
L_pend:
    s_endpgm
L_cons:
    s_setprio 1
    v_lshrrev_b32 v140, 4, v0
    v_and_b32 v141, 7, v0
    v_xor_b32 v141, v141, v140
    v_lshrrev_b32 v140, 3, v0
    v_lshlrev_b32 v140, 11, v140
    v_lshl_add_u32 v136, v141, 4, v140
    v_xor_b32 v137, 64, v136
    v_add_u32 v138, 30720, v136
    v_add_u32 v139, 46080, v137
    v_add_u32 v137, 15360, v137
    s_lshl_b32 s44, s37, 2
    s_add_u32 s44, s44, s38
    s_lshl_b32 s44, s44, 17
    s_add_u32 s52, s44, 65536
    s_lshl_b32 s42, s38, 11
    s_add_u32 m0, s42, 256
    s_mov_b32 s18, 4194304
    s_mov_b32 s19, 0x20000
    s_mov_b32 s26, 229376
    s_mov_b32 s27, 0x20000
    v_lshrrev_b32 v142, 4, v0
    v_mul_u32_u24 v142, 7168, v142
    v_and_b32 v143, 15, v0
    v_lshl_add_u32 v142, v143, 4, v142
    v_add_u32 v143, 27648, v142
    s_mul_i32 s51, s38, 57344
    s_lshl_b32 s42, s36, 8
    s_add_u32 s51, s51, s42
    s_waitcnt lgkmcnt(0)
    s_mov_b32 s24, s10
    s_and_b32 s25, s11, 0xffff
    s_setprio 3
    buffer_load_dwordx4 v142, s[24:27], s51 offen lds
    buffer_load_dwordx4 v143, s[24:27], s51 offen offset:1024 lds
    s_setprio 1
    s_lshl_b32 s42, s38, 13
    s_add_u32 m0, s42, 73984
    s_mov_b32 s16, s4
    s_and_b32 s17, s5, 0xffff
    buffer_load_dwordx4 v136, s[16:19], s44 offen offset:0 lds
    buffer_load_dwordx4 v137, s[16:19], s44 offen offset:1024 lds
    buffer_load_dwordx4 v138, s[16:19], s44 offen offset:2048 lds
    buffer_load_dwordx4 v139, s[16:19], s44 offen offset:3072 lds
    s_add_u32 m0, m0, 4096
    s_nop 0
    buffer_load_dwordx4 v136, s[16:19], s52 offen offset:0 lds
    buffer_load_dwordx4 v137, s[16:19], s52 offen offset:1024 lds
    buffer_load_dwordx4 v138, s[16:19], s52 offen offset:2048 lds
    buffer_load_dwordx4 v139, s[16:19], s52 offen offset:3072 lds
    s_setprio 0
    s_lshr_b32 s40, s38, 1
    s_and_b32 s41, s38, 1
    v_and_b32 v8, 15, v0
    v_lshrrev_b32 v9, 4, v0
    v_lshrrev_b32 v10, 1, v8
    v_xor_b32 v10, v10, v9
    v_lshlrev_b32 v10, 4, v10
    v_lshl_add_u32 v4, v8, 7, v10
    s_lshl_b32 s42, s40, 14
    s_add_u32 s42, s42, 41216
    v_add_u32 v4, s42, v4
    s_lshl_b32 s42, s41, 12
    s_add_u32 s42, s42, 8448
    v_lshl_add_u32 v5, v0, 4, s42
    v_mul_u32_u24 v6, 28672, v9
    v_lshl_add_u32 v6, v8, 3, v6
    s_lshl_b32 s49, s37, 1
    s_add_u32 s49, s49, s40
    s_mul_i32 s49, s49, 917504
    s_lshl_b32 s42, s36, 1
    s_add_u32 s42, s42, s41
    s_lshl_b32 s42, s42, 7
    s_add_u32 s49, s49, s42
    v_add_u32 v1, 32768, v4
    v_xor_b32 v2, 64, v1
    v_mov_b32 v3, v5
    v_mov_b32 v8, 0
    v_mov_b32 v9, 0
    v_mov_b32 v10, 0
    v_mov_b32 v11, 0
    v_mov_b32 v12, 0
    v_mov_b32 v13, 0
    v_mov_b32 v14, 0
    v_mov_b32 v15, 0
    v_mov_b32 v16, 0
    v_mov_b32 v17, 0
    v_mov_b32 v18, 0
    v_mov_b32 v19, 0
    v_mov_b32 v20, 0
    v_mov_b32 v21, 0
    v_mov_b32 v22, 0
    v_mov_b32 v23, 0
    v_mov_b32 v24, 0
    v_mov_b32 v25, 0
    v_mov_b32 v26, 0
    v_mov_b32 v27, 0
    v_mov_b32 v28, 0
    v_mov_b32 v29, 0
    v_mov_b32 v30, 0
    v_mov_b32 v31, 0
    v_mov_b32 v32, 0
    v_mov_b32 v33, 0
    v_mov_b32 v34, 0
    v_mov_b32 v35, 0
    v_mov_b32 v36, 0
    v_mov_b32 v37, 0
    v_mov_b32 v38, 0
    v_mov_b32 v39, 0
    v_mov_b32 v40, 0
    v_mov_b32 v41, 0
    v_mov_b32 v42, 0
    v_mov_b32 v43, 0
    v_mov_b32 v44, 0
    v_mov_b32 v45, 0
    v_mov_b32 v46, 0
    v_mov_b32 v47, 0
    v_mov_b32 v48, 0
    v_mov_b32 v49, 0
    v_mov_b32 v50, 0
    v_mov_b32 v51, 0
    v_mov_b32 v52, 0
    v_mov_b32 v53, 0
    v_mov_b32 v54, 0
    v_mov_b32 v55, 0
    v_mov_b32 v56, 0
    v_mov_b32 v57, 0
    v_mov_b32 v58, 0
    v_mov_b32 v59, 0
    v_mov_b32 v60, 0
    v_mov_b32 v61, 0
    v_mov_b32 v62, 0
    v_mov_b32 v63, 0
    v_mov_b32 v64, 0
    v_mov_b32 v65, 0
    v_mov_b32 v66, 0
    v_mov_b32 v67, 0
    v_mov_b32 v68, 0
    v_mov_b32 v69, 0
    v_mov_b32 v70, 0
    v_mov_b32 v71, 0
    v_mov_b32 v72, 0
    v_mov_b32 v73, 0
    v_mov_b32 v74, 0
    v_mov_b32 v75, 0
    v_mov_b32 v76, 0
    v_mov_b32 v77, 0
    v_mov_b32 v78, 0
    v_mov_b32 v79, 0
    v_mov_b32 v80, 0
    v_mov_b32 v81, 0
    v_mov_b32 v82, 0
    v_mov_b32 v83, 0
    v_mov_b32 v84, 0
    v_mov_b32 v85, 0
    v_mov_b32 v86, 0
    v_mov_b32 v87, 0
    v_mov_b32 v88, 0
    v_mov_b32 v89, 0
    v_mov_b32 v90, 0
    v_mov_b32 v91, 0
    v_mov_b32 v92, 0
    v_mov_b32 v93, 0
    v_mov_b32 v94, 0
    v_mov_b32 v95, 0
    v_mov_b32 v96, 0
    v_mov_b32 v97, 0
    v_mov_b32 v98, 0
    v_mov_b32 v99, 0
    v_mov_b32 v100, 0
    v_mov_b32 v101, 0
    v_mov_b32 v102, 0
    v_mov_b32 v103, 0
    v_mov_b32 v104, 0
    v_mov_b32 v105, 0
    v_mov_b32 v106, 0
    v_mov_b32 v107, 0
    v_mov_b32 v108, 0
    v_mov_b32 v109, 0
    v_mov_b32 v110, 0
    v_mov_b32 v111, 0
    v_mov_b32 v112, 0
    v_mov_b32 v113, 0
    v_mov_b32 v114, 0
    v_mov_b32 v115, 0
    v_mov_b32 v116, 0
    v_mov_b32 v117, 0
    v_mov_b32 v118, 0
    v_mov_b32 v119, 0
    v_mov_b32 v120, 0
    v_mov_b32 v121, 0
    v_mov_b32 v122, 0
    v_mov_b32 v123, 0
    v_mov_b32 v124, 0
    v_mov_b32 v125, 0
    v_mov_b32 v126, 0
    v_mov_b32 v127, 0
    v_mov_b32 v128, 0
    v_mov_b32 v129, 0
    v_mov_b32 v130, 0
    v_mov_b32 v131, 0
    v_mov_b32 v132, 0
    v_mov_b32 v133, 0
    v_mov_b32 v134, 0
    v_mov_b32 v135, 0
    s_mov_b32 s39, 0
    s_mov_b32 s46, 32768
    s_mov_b32 s47, 0
    s_mov_b32 s28, s12
    s_and_b32 s29, s13, 0xffff
    s_mov_b32 s30, 14680064
    s_mov_b32 s31, 0x20000
    s_setprio 2
    s_waitcnt vmcnt(0) lgkmcnt(0)
    s_barrier
    ds_read_b128 v[136:139], v1 offset:0
    ds_read_b128 v[140:143], v1 offset:2048
    ds_read_b128 v[152:155], v3 offset:0
    ds_read_b128 v[156:159], v3 offset:1024
    ds_read_b128 v[160:163], v3 offset:2048
    ds_read_b128 v[164:167], v3 offset:3072
L_cloop:
    s_waitcnt lgkmcnt(3)
    v_mfma_f32_16x16x32_bf16 v[8:11], v[136:139], v[152:155], v[8:11]
    ds_read_b128 v[144:147], v1 offset:4096
    v_mfma_f32_16x16x32_bf16 v[24:27], v[140:143], v[152:155], v[24:27]
    ds_read_b128 v[148:151], v1 offset:6144
    s_waitcnt lgkmcnt(4)
    v_mfma_f32_16x16x32_bf16 v[12:15], v[136:139], v[156:159], v[12:15]
    v_mfma_f32_16x16x32_bf16 v[28:31], v[140:143], v[156:159], v[28:31]
    s_waitcnt lgkmcnt(3)
    v_mfma_f32_16x16x32_bf16 v[16:19], v[136:139], v[160:163], v[16:19]
    v_mfma_f32_16x16x32_bf16 v[32:35], v[140:143], v[160:163], v[32:35]
    s_waitcnt lgkmcnt(2)
    v_mfma_f32_16x16x32_bf16 v[20:23], v[136:139], v[164:167], v[20:23]
    v_mfma_f32_16x16x32_bf16 v[36:39], v[140:143], v[164:167], v[36:39]
    s_waitcnt lgkmcnt(1)
    v_mfma_f32_16x16x32_bf16 v[40:43], v[144:147], v[152:155], v[40:43]
    ds_read_b128 v[136:139], v1 offset:8192
    s_waitcnt lgkmcnt(1)
    v_mfma_f32_16x16x32_bf16 v[56:59], v[148:151], v[152:155], v[56:59]
    ds_read_b128 v[140:143], v1 offset:10240
    v_mfma_f32_16x16x32_bf16 v[44:47], v[144:147], v[156:159], v[44:47]
    v_mfma_f32_16x16x32_bf16 v[60:63], v[148:151], v[156:159], v[60:63]
    v_mfma_f32_16x16x32_bf16 v[48:51], v[144:147], v[160:163], v[48:51]
    v_mfma_f32_16x16x32_bf16 v[64:67], v[148:151], v[160:163], v[64:67]
    v_mfma_f32_16x16x32_bf16 v[52:55], v[144:147], v[164:167], v[52:55]
    v_mfma_f32_16x16x32_bf16 v[68:71], v[148:151], v[164:167], v[68:71]
    s_waitcnt lgkmcnt(1)
    v_mfma_f32_16x16x32_bf16 v[72:75], v[136:139], v[152:155], v[72:75]
    ds_read_b128 v[144:147], v1 offset:12288
    s_waitcnt lgkmcnt(1)
    v_mfma_f32_16x16x32_bf16 v[88:91], v[140:143], v[152:155], v[88:91]
    ds_read_b128 v[148:151], v1 offset:14336
    v_mfma_f32_16x16x32_bf16 v[76:79], v[136:139], v[156:159], v[76:79]
    v_mfma_f32_16x16x32_bf16 v[92:95], v[140:143], v[156:159], v[92:95]
    v_mfma_f32_16x16x32_bf16 v[80:83], v[136:139], v[160:163], v[80:83]
    v_mfma_f32_16x16x32_bf16 v[96:99], v[140:143], v[160:163], v[96:99]
    v_mfma_f32_16x16x32_bf16 v[84:87], v[136:139], v[164:167], v[84:87]
    v_mfma_f32_16x16x32_bf16 v[100:103], v[140:143], v[164:167], v[100:103]
    s_waitcnt lgkmcnt(0)
    ds_read_b128 v[136:139], v2 offset:0
    v_mfma_f32_16x16x32_bf16 v[104:107], v[144:147], v[152:155], v[104:107]
    ds_read_b128 v[140:143], v2 offset:2048
    v_mfma_f32_16x16x32_bf16 v[120:123], v[148:151], v[152:155], v[120:123]
    ds_read_b128 v[152:155], v3 offset:8192
    v_mfma_f32_16x16x32_bf16 v[108:111], v[144:147], v[156:159], v[108:111]
    v_mfma_f32_16x16x32_bf16 v[124:127], v[148:151], v[156:159], v[124:127]
    ds_read_b128 v[156:159], v3 offset:9216
    v_mfma_f32_16x16x32_bf16 v[112:115], v[144:147], v[160:163], v[112:115]
    v_mfma_f32_16x16x32_bf16 v[128:131], v[148:151], v[160:163], v[128:131]
    ds_read_b128 v[160:163], v3 offset:10240
    v_mfma_f32_16x16x32_bf16 v[116:119], v[144:147], v[164:167], v[116:119]
    v_mfma_f32_16x16x32_bf16 v[132:135], v[148:151], v[164:167], v[132:135]
    ds_read_b128 v[164:167], v3 offset:11264
    s_waitcnt lgkmcnt(3)
    v_mfma_f32_16x16x32_bf16 v[8:11], v[136:139], v[152:155], v[8:11]
    ds_read_b128 v[144:147], v2 offset:4096
    v_mfma_f32_16x16x32_bf16 v[24:27], v[140:143], v[152:155], v[24:27]
    ds_read_b128 v[148:151], v2 offset:6144
    s_waitcnt lgkmcnt(4)
    v_mfma_f32_16x16x32_bf16 v[12:15], v[136:139], v[156:159], v[12:15]
    v_mfma_f32_16x16x32_bf16 v[28:31], v[140:143], v[156:159], v[28:31]
    s_waitcnt lgkmcnt(3)
    v_mfma_f32_16x16x32_bf16 v[16:19], v[136:139], v[160:163], v[16:19]
    v_mfma_f32_16x16x32_bf16 v[32:35], v[140:143], v[160:163], v[32:35]
    s_waitcnt lgkmcnt(2)
    v_mfma_f32_16x16x32_bf16 v[20:23], v[136:139], v[164:167], v[20:23]
    v_mfma_f32_16x16x32_bf16 v[36:39], v[140:143], v[164:167], v[36:39]
    s_waitcnt lgkmcnt(1)
    v_mfma_f32_16x16x32_bf16 v[40:43], v[144:147], v[152:155], v[40:43]
    ds_read_b128 v[136:139], v2 offset:8192
    s_waitcnt lgkmcnt(1)
    v_mfma_f32_16x16x32_bf16 v[56:59], v[148:151], v[152:155], v[56:59]
    ds_read_b128 v[140:143], v2 offset:10240
    v_mfma_f32_16x16x32_bf16 v[44:47], v[144:147], v[156:159], v[44:47]
    v_mfma_f32_16x16x32_bf16 v[60:63], v[148:151], v[156:159], v[60:63]
    s_add_u32 s46, s46, 32768
    s_cmp_eq_u32 s46, 98304
    v_mfma_f32_16x16x32_bf16 v[48:51], v[144:147], v[160:163], v[48:51]
    s_cselect_b32 s46, 0, s46
    s_xor_b32 s47, s47, 16384
    v_mfma_f32_16x16x32_bf16 v[64:67], v[148:151], v[160:163], v[64:67]
    v_mfma_f32_16x16x32_bf16 v[52:55], v[144:147], v[164:167], v[52:55]
    v_mfma_f32_16x16x32_bf16 v[68:71], v[148:151], v[164:167], v[68:71]
    s_waitcnt lgkmcnt(1)
    v_mfma_f32_16x16x32_bf16 v[72:75], v[136:139], v[152:155], v[72:75]
    ds_read_b128 v[144:147], v2 offset:12288
    s_waitcnt lgkmcnt(1)
    v_mfma_f32_16x16x32_bf16 v[88:91], v[140:143], v[152:155], v[88:91]
    ds_read_b128 v[148:151], v2 offset:14336
    v_mfma_f32_16x16x32_bf16 v[76:79], v[136:139], v[156:159], v[76:79]
    v_mfma_f32_16x16x32_bf16 v[92:95], v[140:143], v[156:159], v[92:95]
    v_mfma_f32_16x16x32_bf16 v[80:83], v[136:139], v[160:163], v[80:83]
    v_add_u32 v1, s46, v4
    v_add_u32 v3, s47, v5
    v_mfma_f32_16x16x32_bf16 v[96:99], v[140:143], v[160:163], v[96:99]
    v_xor_b32 v2, 64, v1
    s_add_u32 s39, s39, 1
    v_mfma_f32_16x16x32_bf16 v[84:87], v[136:139], v[164:167], v[84:87]
    v_mfma_f32_16x16x32_bf16 v[100:103], v[140:143], v[164:167], v[100:103]
    s_waitcnt lgkmcnt(0)
    s_barrier
    ds_read_b128 v[136:139], v1 offset:0
    v_mfma_f32_16x16x32_bf16 v[104:107], v[144:147], v[152:155], v[104:107]
    ds_read_b128 v[140:143], v1 offset:2048
    v_mfma_f32_16x16x32_bf16 v[120:123], v[148:151], v[152:155], v[120:123]
    ds_read_b128 v[152:155], v3 offset:0
    v_mfma_f32_16x16x32_bf16 v[108:111], v[144:147], v[156:159], v[108:111]
    v_mfma_f32_16x16x32_bf16 v[124:127], v[148:151], v[156:159], v[124:127]
    ds_read_b128 v[156:159], v3 offset:1024
    s_cmp_lg_u32 s39, 14
    v_mfma_f32_16x16x32_bf16 v[112:115], v[144:147], v[160:163], v[112:115]
    v_mfma_f32_16x16x32_bf16 v[128:131], v[148:151], v[160:163], v[128:131]
    ds_read_b128 v[160:163], v3 offset:2048
    v_mfma_f32_16x16x32_bf16 v[116:119], v[144:147], v[164:167], v[116:119]
    v_mfma_f32_16x16x32_bf16 v[132:135], v[148:151], v[164:167], v[132:135]
    ds_read_b128 v[164:167], v3 offset:3072
    s_cbranch_scc1 L_cloop
    s_waitcnt lgkmcnt(3)
    v_mfma_f32_16x16x32_bf16 v[8:11], v[136:139], v[152:155], v[8:11]
    ds_read_b128 v[144:147], v1 offset:4096
    v_mfma_f32_16x16x32_bf16 v[24:27], v[140:143], v[152:155], v[24:27]
    ds_read_b128 v[148:151], v1 offset:6144
    s_waitcnt lgkmcnt(4)
    v_mfma_f32_16x16x32_bf16 v[12:15], v[136:139], v[156:159], v[12:15]
    v_mfma_f32_16x16x32_bf16 v[28:31], v[140:143], v[156:159], v[28:31]
    s_waitcnt lgkmcnt(3)
    v_mfma_f32_16x16x32_bf16 v[16:19], v[136:139], v[160:163], v[16:19]
    v_mfma_f32_16x16x32_bf16 v[32:35], v[140:143], v[160:163], v[32:35]
    s_waitcnt lgkmcnt(2)
    v_mfma_f32_16x16x32_bf16 v[20:23], v[136:139], v[164:167], v[20:23]
    v_mfma_f32_16x16x32_bf16 v[36:39], v[140:143], v[164:167], v[36:39]
    s_waitcnt lgkmcnt(1)
    v_mfma_f32_16x16x32_bf16 v[40:43], v[144:147], v[152:155], v[40:43]
    ds_read_b128 v[136:139], v1 offset:8192
    s_waitcnt lgkmcnt(1)
    v_mfma_f32_16x16x32_bf16 v[56:59], v[148:151], v[152:155], v[56:59]
    ds_read_b128 v[140:143], v1 offset:10240
    v_mfma_f32_16x16x32_bf16 v[44:47], v[144:147], v[156:159], v[44:47]
    v_mfma_f32_16x16x32_bf16 v[60:63], v[148:151], v[156:159], v[60:63]
    v_mfma_f32_16x16x32_bf16 v[48:51], v[144:147], v[160:163], v[48:51]
    v_mfma_f32_16x16x32_bf16 v[64:67], v[148:151], v[160:163], v[64:67]
    v_mfma_f32_16x16x32_bf16 v[52:55], v[144:147], v[164:167], v[52:55]
    v_mfma_f32_16x16x32_bf16 v[68:71], v[148:151], v[164:167], v[68:71]
    s_waitcnt lgkmcnt(1)
    v_mfma_f32_16x16x32_bf16 v[72:75], v[136:139], v[152:155], v[72:75]
    ds_read_b128 v[144:147], v2 offset:0
    s_waitcnt lgkmcnt(1)
    v_mfma_f32_16x16x32_bf16 v[88:91], v[140:143], v[152:155], v[88:91]
    ds_read_b128 v[148:151], v2 offset:2048
    ds_read_b128 v[152:155], v3 offset:8192
    v_mfma_f32_16x16x32_bf16 v[76:79], v[136:139], v[156:159], v[76:79]
    v_mfma_f32_16x16x32_bf16 v[92:95], v[140:143], v[156:159], v[92:95]
    ds_read_b128 v[156:159], v3 offset:9216
    v_mfma_f32_16x16x32_bf16 v[80:83], v[136:139], v[160:163], v[80:83]
    v_mfma_f32_16x16x32_bf16 v[96:99], v[140:143], v[160:163], v[96:99]
    ds_read_b128 v[160:163], v3 offset:10240
    v_mfma_f32_16x16x32_bf16 v[84:87], v[136:139], v[164:167], v[84:87]
    v_mfma_f32_16x16x32_bf16 v[100:103], v[140:143], v[164:167], v[100:103]
    ds_read_b128 v[164:167], v3 offset:11264
    s_waitcnt lgkmcnt(3)
    v_mfma_f32_16x16x32_bf16 v[8:11], v[144:147], v[152:155], v[8:11]
    ds_read_b128 v[136:139], v2 offset:4096
    v_mfma_f32_16x16x32_bf16 v[24:27], v[148:151], v[152:155], v[24:27]
    ds_read_b128 v[140:143], v2 offset:6144
    s_waitcnt lgkmcnt(4)
    v_mfma_f32_16x16x32_bf16 v[12:15], v[144:147], v[156:159], v[12:15]
    v_mfma_f32_16x16x32_bf16 v[28:31], v[148:151], v[156:159], v[28:31]
    s_waitcnt lgkmcnt(3)
    v_mfma_f32_16x16x32_bf16 v[16:19], v[144:147], v[160:163], v[16:19]
    v_mfma_f32_16x16x32_bf16 v[32:35], v[148:151], v[160:163], v[32:35]
    s_waitcnt lgkmcnt(2)
    v_mfma_f32_16x16x32_bf16 v[20:23], v[144:147], v[164:167], v[20:23]
    v_mfma_f32_16x16x32_bf16 v[36:39], v[148:151], v[164:167], v[36:39]
    s_waitcnt lgkmcnt(1)
    v_mfma_f32_16x16x32_bf16 v[40:43], v[136:139], v[152:155], v[40:43]
    ds_read_b128 v[144:147], v2 offset:8192
    s_waitcnt lgkmcnt(1)
    v_mfma_f32_16x16x32_bf16 v[56:59], v[140:143], v[152:155], v[56:59]
    ds_read_b128 v[148:151], v2 offset:10240
    v_mfma_f32_16x16x32_bf16 v[44:47], v[136:139], v[156:159], v[44:47]
    v_mfma_f32_16x16x32_bf16 v[60:63], v[140:143], v[156:159], v[60:63]
    v_mfma_f32_16x16x32_bf16 v[48:51], v[136:139], v[160:163], v[48:51]
    v_mfma_f32_16x16x32_bf16 v[64:67], v[140:143], v[160:163], v[64:67]
    v_mfma_f32_16x16x32_bf16 v[52:55], v[136:139], v[164:167], v[52:55]
    v_mfma_f32_16x16x32_bf16 v[68:71], v[140:143], v[164:167], v[68:71]
    s_barrier
    s_waitcnt lgkmcnt(1)
    v_mfma_f32_16x16x32_bf16 v[72:75], v[144:147], v[152:155], v[72:75]
    ds_read_b128 v[136:139], v2 offset:32768
    s_waitcnt lgkmcnt(1)
    v_mfma_f32_16x16x32_bf16 v[88:91], v[148:151], v[152:155], v[88:91]
    ds_read_b128 v[140:143], v2 offset:34816
    ds_read_b128 v[152:155], v3 offset:24576
    v_mfma_f32_16x16x32_bf16 v[76:79], v[144:147], v[156:159], v[76:79]
    v_mfma_f32_16x16x32_bf16 v[92:95], v[148:151], v[156:159], v[92:95]
    ds_read_b128 v[156:159], v3 offset:25600
    v_mfma_f32_16x16x32_bf16 v[80:83], v[144:147], v[160:163], v[80:83]
    v_mfma_f32_16x16x32_bf16 v[96:99], v[148:151], v[160:163], v[96:99]
    ds_read_b128 v[160:163], v3 offset:26624
    v_mfma_f32_16x16x32_bf16 v[84:87], v[144:147], v[164:167], v[84:87]
    v_mfma_f32_16x16x32_bf16 v[100:103], v[148:151], v[164:167], v[100:103]
    ds_read_b128 v[164:167], v3 offset:27648
    s_waitcnt lgkmcnt(3)
    v_mfma_f32_16x16x32_bf16 v[8:11], v[136:139], v[152:155], v[8:11]
    ds_read_b128 v[144:147], v1 offset:32768
    v_mfma_f32_16x16x32_bf16 v[24:27], v[140:143], v[152:155], v[24:27]
    ds_read_b128 v[148:151], v1 offset:34816
    ds_read_b128 v[152:155], v3 offset:16384
    s_waitcnt lgkmcnt(5)
    v_mfma_f32_16x16x32_bf16 v[12:15], v[136:139], v[156:159], v[12:15]
    v_mfma_f32_16x16x32_bf16 v[28:31], v[140:143], v[156:159], v[28:31]
    ds_read_b128 v[156:159], v3 offset:17408
    s_waitcnt lgkmcnt(5)
    v_mfma_f32_16x16x32_bf16 v[16:19], v[136:139], v[160:163], v[16:19]
    v_mfma_f32_16x16x32_bf16 v[32:35], v[140:143], v[160:163], v[32:35]
    ds_read_b128 v[160:163], v3 offset:18432
    s_waitcnt lgkmcnt(5)
    v_mfma_f32_16x16x32_bf16 v[20:23], v[136:139], v[164:167], v[20:23]
    v_mfma_f32_16x16x32_bf16 v[36:39], v[140:143], v[164:167], v[36:39]
    ds_read_b128 v[164:167], v3 offset:19456
    s_waitcnt lgkmcnt(3)
    v_mfma_f32_16x16x32_bf16 v[8:11], v[144:147], v[152:155], v[8:11]
    ds_read_b128 v[136:139], v1 offset:36864
    v_mfma_f32_16x16x32_bf16 v[24:27], v[148:151], v[152:155], v[24:27]
    ds_read_b128 v[140:143], v1 offset:38912
    s_waitcnt lgkmcnt(4)
    v_mfma_f32_16x16x32_bf16 v[12:15], v[144:147], v[156:159], v[12:15]
    v_mfma_f32_16x16x32_bf16 v[28:31], v[148:151], v[156:159], v[28:31]
    s_waitcnt lgkmcnt(3)
    v_mfma_f32_16x16x32_bf16 v[16:19], v[144:147], v[160:163], v[16:19]
    v_mfma_f32_16x16x32_bf16 v[32:35], v[148:151], v[160:163], v[32:35]
    s_waitcnt lgkmcnt(2)
    v_mfma_f32_16x16x32_bf16 v[20:23], v[144:147], v[164:167], v[20:23]
    v_mfma_f32_16x16x32_bf16 v[36:39], v[148:151], v[164:167], v[36:39]
    s_waitcnt lgkmcnt(1)
    v_mfma_f32_16x16x32_bf16 v[40:43], v[136:139], v[152:155], v[40:43]
    ds_read_b128 v[144:147], v2 offset:36864
    s_waitcnt lgkmcnt(1)
    v_mfma_f32_16x16x32_bf16 v[56:59], v[140:143], v[152:155], v[56:59]
    ds_read_b128 v[148:151], v2 offset:38912
    ds_read_b128 v[152:155], v3 offset:24576
    v_mfma_f32_16x16x32_bf16 v[44:47], v[136:139], v[156:159], v[44:47]
    v_mfma_f32_16x16x32_bf16 v[60:63], v[140:143], v[156:159], v[60:63]
    ds_read_b128 v[156:159], v3 offset:25600
    v_cvt_pk_bf16_f32 v4, v8, v12
    v_cvt_pk_bf16_f32 v5, v16, v20
    buffer_store_dwordx2 v[4:5], v6, s[28:31], s49 offen nt
    s_add_u32 s49, s49, 7168
    v_mfma_f32_16x16x32_bf16 v[48:51], v[136:139], v[160:163], v[48:51]
    v_mfma_f32_16x16x32_bf16 v[64:67], v[140:143], v[160:163], v[64:67]
    ds_read_b128 v[160:163], v3 offset:26624
    v_cvt_pk_bf16_f32 v8, v9, v13
    v_cvt_pk_bf16_f32 v9, v17, v21
    buffer_store_dwordx2 v[8:9], v6, s[28:31], s49 offen nt
    s_add_u32 s49, s49, 7168
    v_mfma_f32_16x16x32_bf16 v[52:55], v[136:139], v[164:167], v[52:55]
    v_mfma_f32_16x16x32_bf16 v[68:71], v[140:143], v[164:167], v[68:71]
    ds_read_b128 v[164:167], v3 offset:27648
    v_cvt_pk_bf16_f32 v12, v10, v14
    v_cvt_pk_bf16_f32 v13, v18, v22
    buffer_store_dwordx2 v[12:13], v6, s[28:31], s49 offen nt
    s_add_u32 s49, s49, 7168
    s_waitcnt lgkmcnt(3)
    v_mfma_f32_16x16x32_bf16 v[40:43], v[144:147], v[152:155], v[40:43]
    ds_read_b128 v[136:139], v2 offset:40960
    v_mfma_f32_16x16x32_bf16 v[56:59], v[148:151], v[152:155], v[56:59]
    ds_read_b128 v[140:143], v2 offset:43008
    v_cvt_pk_bf16_f32 v16, v11, v15
    v_cvt_pk_bf16_f32 v17, v19, v23
    buffer_store_dwordx2 v[16:17], v6, s[28:31], s49 offen nt
    s_add_u32 s49, s49, 93184
    s_waitcnt lgkmcnt(4)
    v_mfma_f32_16x16x32_bf16 v[44:47], v[144:147], v[156:159], v[44:47]
    v_mfma_f32_16x16x32_bf16 v[60:63], v[148:151], v[156:159], v[60:63]
    v_cvt_pk_bf16_f32 v20, v24, v28
    v_cvt_pk_bf16_f32 v21, v32, v36
    buffer_store_dwordx2 v[20:21], v6, s[28:31], s49 offen nt
    s_add_u32 s49, s49, 7168
    s_waitcnt lgkmcnt(3)
    v_mfma_f32_16x16x32_bf16 v[48:51], v[144:147], v[160:163], v[48:51]
    v_mfma_f32_16x16x32_bf16 v[64:67], v[148:151], v[160:163], v[64:67]
    v_cvt_pk_bf16_f32 v24, v25, v29
    v_cvt_pk_bf16_f32 v25, v33, v37
    buffer_store_dwordx2 v[24:25], v6, s[28:31], s49 offen nt
    s_add_u32 s49, s49, 7168
    s_waitcnt lgkmcnt(2)
    v_mfma_f32_16x16x32_bf16 v[52:55], v[144:147], v[164:167], v[52:55]
    v_mfma_f32_16x16x32_bf16 v[68:71], v[148:151], v[164:167], v[68:71]
    v_cvt_pk_bf16_f32 v28, v26, v30
    v_cvt_pk_bf16_f32 v29, v34, v38
    buffer_store_dwordx2 v[28:29], v6, s[28:31], s49 offen nt
    s_add_u32 s49, s49, 7168
    s_waitcnt lgkmcnt(1)
    v_mfma_f32_16x16x32_bf16 v[72:75], v[136:139], v[152:155], v[72:75]
    ds_read_b128 v[144:147], v1 offset:40960
    s_waitcnt lgkmcnt(1)
    v_mfma_f32_16x16x32_bf16 v[88:91], v[140:143], v[152:155], v[88:91]
    ds_read_b128 v[148:151], v1 offset:43008
    ds_read_b128 v[152:155], v3 offset:16384
    v_mfma_f32_16x16x32_bf16 v[76:79], v[136:139], v[156:159], v[76:79]
    v_mfma_f32_16x16x32_bf16 v[92:95], v[140:143], v[156:159], v[92:95]
    ds_read_b128 v[156:159], v3 offset:17408
    v_cvt_pk_bf16_f32 v32, v27, v31
    v_cvt_pk_bf16_f32 v33, v35, v39
    buffer_store_dwordx2 v[32:33], v6, s[28:31], s49 offen nt
    s_add_u32 s49, s49, 93184
    v_mfma_f32_16x16x32_bf16 v[80:83], v[136:139], v[160:163], v[80:83]
    v_mfma_f32_16x16x32_bf16 v[96:99], v[140:143], v[160:163], v[96:99]
    ds_read_b128 v[160:163], v3 offset:18432
    v_cvt_pk_bf16_f32 v36, v40, v44
    v_cvt_pk_bf16_f32 v37, v48, v52
    buffer_store_dwordx2 v[36:37], v6, s[28:31], s49 offen nt
    s_add_u32 s49, s49, 7168
    v_mfma_f32_16x16x32_bf16 v[84:87], v[136:139], v[164:167], v[84:87]
    v_mfma_f32_16x16x32_bf16 v[100:103], v[140:143], v[164:167], v[100:103]
    ds_read_b128 v[164:167], v3 offset:19456
    v_cvt_pk_bf16_f32 v40, v41, v45
    v_cvt_pk_bf16_f32 v41, v49, v53
    buffer_store_dwordx2 v[40:41], v6, s[28:31], s49 offen nt
    s_add_u32 s49, s49, 7168
    s_waitcnt lgkmcnt(3)
    v_mfma_f32_16x16x32_bf16 v[72:75], v[144:147], v[152:155], v[72:75]
    ds_read_b128 v[136:139], v1 offset:45056
    v_mfma_f32_16x16x32_bf16 v[88:91], v[148:151], v[152:155], v[88:91]
    ds_read_b128 v[140:143], v1 offset:47104
    v_cvt_pk_bf16_f32 v44, v42, v46
    v_cvt_pk_bf16_f32 v45, v50, v54
    buffer_store_dwordx2 v[44:45], v6, s[28:31], s49 offen nt
    s_add_u32 s49, s49, 7168
    s_waitcnt lgkmcnt(4)
    v_mfma_f32_16x16x32_bf16 v[76:79], v[144:147], v[156:159], v[76:79]
    v_mfma_f32_16x16x32_bf16 v[92:95], v[148:151], v[156:159], v[92:95]
    v_cvt_pk_bf16_f32 v48, v43, v47
    v_cvt_pk_bf16_f32 v49, v51, v55
    buffer_store_dwordx2 v[48:49], v6, s[28:31], s49 offen nt
    s_add_u32 s49, s49, 93184
    s_waitcnt lgkmcnt(3)
    v_mfma_f32_16x16x32_bf16 v[80:83], v[144:147], v[160:163], v[80:83]
    v_mfma_f32_16x16x32_bf16 v[96:99], v[148:151], v[160:163], v[96:99]
    v_cvt_pk_bf16_f32 v52, v56, v60
    v_cvt_pk_bf16_f32 v53, v64, v68
    buffer_store_dwordx2 v[52:53], v6, s[28:31], s49 offen nt
    s_add_u32 s49, s49, 7168
    s_waitcnt lgkmcnt(2)
    v_mfma_f32_16x16x32_bf16 v[84:87], v[144:147], v[164:167], v[84:87]
    v_mfma_f32_16x16x32_bf16 v[100:103], v[148:151], v[164:167], v[100:103]
    v_cvt_pk_bf16_f32 v56, v57, v61
    v_cvt_pk_bf16_f32 v57, v65, v69
    buffer_store_dwordx2 v[56:57], v6, s[28:31], s49 offen nt
    s_add_u32 s49, s49, 7168
    s_waitcnt lgkmcnt(1)
    v_mfma_f32_16x16x32_bf16 v[104:107], v[136:139], v[152:155], v[104:107]
    ds_read_b128 v[144:147], v2 offset:45056
    s_waitcnt lgkmcnt(1)
    v_mfma_f32_16x16x32_bf16 v[120:123], v[140:143], v[152:155], v[120:123]
    ds_read_b128 v[148:151], v2 offset:47104
    ds_read_b128 v[152:155], v3 offset:24576
    v_mfma_f32_16x16x32_bf16 v[108:111], v[136:139], v[156:159], v[108:111]
    v_mfma_f32_16x16x32_bf16 v[124:127], v[140:143], v[156:159], v[124:127]
    ds_read_b128 v[156:159], v3 offset:25600
    v_cvt_pk_bf16_f32 v60, v58, v62
    v_cvt_pk_bf16_f32 v61, v66, v70
    buffer_store_dwordx2 v[60:61], v6, s[28:31], s49 offen nt
    s_add_u32 s49, s49, 7168
    v_mfma_f32_16x16x32_bf16 v[112:115], v[136:139], v[160:163], v[112:115]
    v_mfma_f32_16x16x32_bf16 v[128:131], v[140:143], v[160:163], v[128:131]
    ds_read_b128 v[160:163], v3 offset:26624
    v_cvt_pk_bf16_f32 v64, v59, v63
    v_cvt_pk_bf16_f32 v65, v67, v71
    buffer_store_dwordx2 v[64:65], v6, s[28:31], s49 offen nt
    s_add_u32 s49, s49, 93184
    v_mfma_f32_16x16x32_bf16 v[116:119], v[136:139], v[164:167], v[116:119]
    v_mfma_f32_16x16x32_bf16 v[132:135], v[140:143], v[164:167], v[132:135]
    ds_read_b128 v[164:167], v3 offset:27648
    v_cvt_pk_bf16_f32 v68, v72, v76
    v_cvt_pk_bf16_f32 v69, v80, v84
    buffer_store_dwordx2 v[68:69], v6, s[28:31], s49 offen nt
    s_add_u32 s49, s49, 7168
    s_waitcnt lgkmcnt(3)
    v_mfma_f32_16x16x32_bf16 v[104:107], v[144:147], v[152:155], v[104:107]
    ds_read_b128 v[136:139], v2 offset:12288
    v_mfma_f32_16x16x32_bf16 v[120:123], v[148:151], v[152:155], v[120:123]
    ds_read_b128 v[140:143], v2 offset:14336
    ds_read_b128 v[152:155], v3 offset:8192
    v_cvt_pk_bf16_f32 v72, v73, v77
    v_cvt_pk_bf16_f32 v73, v81, v85
    buffer_store_dwordx2 v[72:73], v6, s[28:31], s49 offen nt
    s_add_u32 s49, s49, 7168
    s_waitcnt lgkmcnt(5)
    v_mfma_f32_16x16x32_bf16 v[108:111], v[144:147], v[156:159], v[108:111]
    v_mfma_f32_16x16x32_bf16 v[124:127], v[148:151], v[156:159], v[124:127]
    ds_read_b128 v[156:159], v3 offset:9216
    v_cvt_pk_bf16_f32 v76, v74, v78
    v_cvt_pk_bf16_f32 v77, v82, v86
    buffer_store_dwordx2 v[76:77], v6, s[28:31], s49 offen nt
    s_add_u32 s49, s49, 7168
    s_waitcnt lgkmcnt(5)
    v_mfma_f32_16x16x32_bf16 v[112:115], v[144:147], v[160:163], v[112:115]
    v_mfma_f32_16x16x32_bf16 v[128:131], v[148:151], v[160:163], v[128:131]
    ds_read_b128 v[160:163], v3 offset:10240
    v_cvt_pk_bf16_f32 v80, v75, v79
    v_cvt_pk_bf16_f32 v81, v83, v87
    buffer_store_dwordx2 v[80:81], v6, s[28:31], s49 offen nt
    s_add_u32 s49, s49, 93184
    s_waitcnt lgkmcnt(5)
    v_mfma_f32_16x16x32_bf16 v[116:119], v[144:147], v[164:167], v[116:119]
    v_mfma_f32_16x16x32_bf16 v[132:135], v[148:151], v[164:167], v[132:135]
    ds_read_b128 v[164:167], v3 offset:11264
    v_cvt_pk_bf16_f32 v84, v88, v92
    v_cvt_pk_bf16_f32 v85, v96, v100
    buffer_store_dwordx2 v[84:85], v6, s[28:31], s49 offen nt
    s_add_u32 s49, s49, 7168
    s_waitcnt lgkmcnt(3)
    v_mfma_f32_16x16x32_bf16 v[104:107], v[136:139], v[152:155], v[104:107]
    ds_read_b128 v[144:147], v1 offset:12288
    v_mfma_f32_16x16x32_bf16 v[120:123], v[140:143], v[152:155], v[120:123]
    ds_read_b128 v[148:151], v1 offset:14336
    ds_read_b128 v[152:155], v3 offset:0
    v_cvt_pk_bf16_f32 v88, v89, v93
    v_cvt_pk_bf16_f32 v89, v97, v101
    buffer_store_dwordx2 v[88:89], v6, s[28:31], s49 offen nt
    s_add_u32 s49, s49, 7168
    s_waitcnt lgkmcnt(5)
    v_mfma_f32_16x16x32_bf16 v[108:111], v[136:139], v[156:159], v[108:111]
    v_mfma_f32_16x16x32_bf16 v[124:127], v[140:143], v[156:159], v[124:127]
    ds_read_b128 v[156:159], v3 offset:1024
    v_cvt_pk_bf16_f32 v92, v90, v94
    v_cvt_pk_bf16_f32 v93, v98, v102
    buffer_store_dwordx2 v[92:93], v6, s[28:31], s49 offen nt
    s_add_u32 s49, s49, 7168
    s_waitcnt lgkmcnt(5)
    v_mfma_f32_16x16x32_bf16 v[112:115], v[136:139], v[160:163], v[112:115]
    v_mfma_f32_16x16x32_bf16 v[128:131], v[140:143], v[160:163], v[128:131]
    ds_read_b128 v[160:163], v3 offset:2048
    v_cvt_pk_bf16_f32 v96, v91, v95
    v_cvt_pk_bf16_f32 v97, v99, v103
    buffer_store_dwordx2 v[96:97], v6, s[28:31], s49 offen nt
    s_add_u32 s49, s49, 93184
    s_waitcnt lgkmcnt(5)
    v_mfma_f32_16x16x32_bf16 v[116:119], v[136:139], v[164:167], v[116:119]
    v_mfma_f32_16x16x32_bf16 v[132:135], v[140:143], v[164:167], v[132:135]
    ds_read_b128 v[164:167], v3 offset:3072
    s_waitcnt lgkmcnt(3)
    v_mfma_f32_16x16x32_bf16 v[104:107], v[144:147], v[152:155], v[104:107]
    v_mfma_f32_16x16x32_bf16 v[120:123], v[148:151], v[152:155], v[120:123]
    s_waitcnt lgkmcnt(2)
    v_mfma_f32_16x16x32_bf16 v[108:111], v[144:147], v[156:159], v[108:111]
    v_mfma_f32_16x16x32_bf16 v[124:127], v[148:151], v[156:159], v[124:127]
    s_waitcnt lgkmcnt(1)
    v_mfma_f32_16x16x32_bf16 v[112:115], v[144:147], v[160:163], v[112:115]
    v_mfma_f32_16x16x32_bf16 v[128:131], v[148:151], v[160:163], v[128:131]
    s_waitcnt lgkmcnt(0)
    v_mfma_f32_16x16x32_bf16 v[116:119], v[144:147], v[164:167], v[116:119]
    v_mfma_f32_16x16x32_bf16 v[132:135], v[148:151], v[164:167], v[132:135]
    s_nop 7
    v_cvt_pk_bf16_f32 v100, v104, v108
    v_cvt_pk_bf16_f32 v101, v112, v116
    buffer_store_dwordx2 v[100:101], v6, s[28:31], s49 offen nt
    s_add_u32 s49, s49, 7168
    v_cvt_pk_bf16_f32 v104, v105, v109
    v_cvt_pk_bf16_f32 v105, v113, v117
    buffer_store_dwordx2 v[104:105], v6, s[28:31], s49 offen nt
    s_add_u32 s49, s49, 7168
    v_cvt_pk_bf16_f32 v108, v106, v110
    v_cvt_pk_bf16_f32 v109, v114, v118
    buffer_store_dwordx2 v[108:109], v6, s[28:31], s49 offen nt
    s_add_u32 s49, s49, 7168
    v_cvt_pk_bf16_f32 v112, v107, v111
    v_cvt_pk_bf16_f32 v113, v115, v119
    buffer_store_dwordx2 v[112:113], v6, s[28:31], s49 offen nt
    s_add_u32 s49, s49, 93184
    v_cvt_pk_bf16_f32 v116, v120, v124
    v_cvt_pk_bf16_f32 v117, v128, v132
    buffer_store_dwordx2 v[116:117], v6, s[28:31], s49 offen nt
    s_add_u32 s49, s49, 7168
    v_cvt_pk_bf16_f32 v120, v121, v125
    v_cvt_pk_bf16_f32 v121, v129, v133
    buffer_store_dwordx2 v[120:121], v6, s[28:31], s49 offen nt
    s_add_u32 s49, s49, 7168
    v_cvt_pk_bf16_f32 v124, v122, v126
    v_cvt_pk_bf16_f32 v125, v130, v134
    buffer_store_dwordx2 v[124:125], v6, s[28:31], s49 offen nt
    s_add_u32 s49, s49, 7168
    v_cvt_pk_bf16_f32 v128, v123, v127
    v_cvt_pk_bf16_f32 v129, v131, v135
    buffer_store_dwordx2 v[128:129], v6, s[28:31], s49 offen nt
    s_add_u32 s49, s49, 93184
    s_endpgm
L_end:
    s_endpgm
.section .rodata,"a"
.p2align 6
.amdhsa_kernel standalone__normalfloat_lut_codebook_lookup__prompt_kernel
  .amdhsa_next_free_vgpr 168
  .amdhsa_next_free_sgpr 80
  .amdhsa_accum_offset 168
  .amdhsa_group_segment_fixed_size 0
  .amdhsa_kernarg_size 56
  .amdhsa_user_sgpr_count 2
  .amdhsa_user_sgpr_kernarg_segment_ptr 1
  .amdhsa_system_sgpr_workgroup_id_x 1
  .amdhsa_float_denorm_mode_32 3
.end_amdhsa_kernel
```
